```python
import torch

def _softmax(x, axis=-1):
    return torch.softmax(x, dim=axis)
def _gelu(x):
    return torch.nn.functional.gelu(x, approximate="tanh")
def _silu(x):
    return torch.nn.functional.silu(x)
def _sigmoid(x):
    return torch.sigmoid(x)
def _layernorm(x, axis=-1, eps=1e-5):
    m = x.mean(dim=axis, keepdim=True)
    v = x.var(dim=axis, keepdim=True, unbiased=False)
    return (x - m) / torch.sqrt(v + eps)
def _scatter_add(tgt, idx, src, axis=0):
    return tgt.clone().index_add_(axis, idx, src)
def _segment_sum(src, seg, n):
    out = torch.zeros((n,) + src.shape[1:], dtype=src.dtype)
    return out.index_add_(0, seg, src)
def _pad(x, pw):
    flat = tuple(v for pair in reversed(pw) for v in pair)
    return torch.nn.functional.pad(x, flat)

kernel_name = 'recurrent_scan__sliding_block_cached__glu_gated_bilinear__decode'

def setup_inputs():

    _w = (lambda a: (lambda t: t.to(torch.bfloat16) if t.is_floating_point() else t)(torch.as_tensor(a)))
    def _A_setup():
        B, Sq, D = 8, 1, 512
        Hq, Hkv, Sk, Dh = 32, 8, 4096, 128
        assert Hq % Hkv == 0, (Hq, Hkv)
        return {
            "x": _w((lambda *s: torch.randn(*s, dtype=torch.bfloat16) * 0.05)(B, Sq, D)),
            "k_cache": _w((lambda *s: torch.randn(*s, dtype=torch.bfloat16) * 3.2)(B, Hkv, Sk, Dh)),
            "v_cache": _w((lambda *s: torch.randn(*s, dtype=torch.bfloat16) * 3.2)(B, Hkv, Sk, Dh)),
            "wq": _w((lambda *s: torch.randn(*s, dtype=torch.bfloat16) * 3.2)(D, Hq * Dh) * (D ** -0.5)),
            "wo": _w((lambda *s: torch.randn(*s, dtype=torch.bfloat16) * 3.2)(Hq * Dh, D) * ((Hq * Dh) ** -0.5)),
        }
    _A_in = _A_setup()

    def _B_setup():
        B, S, D, F = 8, 1, 512, 1792
        return {
            "x": _w((lambda *s: torch.randn(*s, dtype=torch.bfloat16) * 0.05)(B, S, D)),
            "w_gate": _w((lambda *s: torch.randn(*s, dtype=torch.bfloat16) * 0.4)(D, F) * (D ** -0.5)),
            "w_up": _w((lambda *s: torch.randn(*s, dtype=torch.bfloat16) * 0.4)(D, F) * (D ** -0.5)),
            "w_down": _w((lambda *s: torch.randn(*s, dtype=torch.bfloat16) * 0.4)(F, D) * (F ** -0.5)),
        }
    _B_in = _B_setup()

    return {
        "A_x": _A_in["x"],
        "A_k_cache": _A_in["k_cache"],
        "A_v_cache": _A_in["v_cache"],
        "A_wq": _A_in["wq"],
        "A_wo": _A_in["wo"],
        "B_x": _B_in["x"],
        "B_w_gate": _B_in["w_gate"],
        "B_w_up": _B_in["w_up"],
        "B_w_down": _B_in["w_down"],
    }

def reference(A_x, A_k_cache, A_v_cache, A_wq, A_wo, B_x, B_w_gate, B_w_up, B_w_down):
    def _A_ref(x, k_cache, v_cache, wq, wo):
        B, Sq, D = x.shape
        Hq, Dh = 32, 128
        Hkv, Sk = k_cache.shape[1], k_cache.shape[2]
        W = min(4096, max(256, Sk // 4))
        rep = Hq // Hkv
        q = (lambda x, *d: x.permute(*d))((x @ wq).reshape(B, Sq, Hq, Dh), 0, 2, 1, 3)
        k = (lambda x, n, axis: torch.repeat_interleave(x, n, dim=axis))(k_cache[:, :, Sk - W:, :], rep, axis=1)
        v = (lambda x, n, axis: torch.repeat_interleave(x, n, dim=axis))(v_cache[:, :, Sk - W:, :], rep, axis=1)
        scores = torch.einsum("bhqd,bhkd->bhqk", q, k) * (Dh ** -0.5)
        p = _softmax(scores, axis=-1)
        o = torch.einsum("bhqk,bhkd->bhqd", p, v)
        return (lambda x, *d: x.permute(*d))(o, 0, 2, 1, 3).reshape(B, Sq, Hq * Dh) @ wo

    def _B_ref(x, w_gate, w_up, w_down):
        g = torch.einsum("bsd,df->bsf", x, w_gate)
        u = torch.einsum("bsd,df->bsf", x, w_up)
        h = g * u
        return torch.einsum("bsf,fd->bsd", h, w_down)

    x = A_x
    xn = _layernorm(x, axis=-1)
    s = _A_ref(xn, A_k_cache, A_v_cache, A_wq, A_wo)
    g = _silu(_B_ref(xn, B_w_gate, B_w_up, B_w_down))
    return x + s * g
```

```asm
; @launch grid=(256,1,1) block=(256,1,1) lds=51456
.amdgcn_target "amdgcn-amd-amdhsa--gfx950"
.text
.globl recurrent_scan__sliding_block_cached__glu_gated_bilinear__decode_kernel
.p2align 8
.type recurrent_scan__sliding_block_cached__glu_gated_bilinear__decode_kernel,@function
recurrent_scan__sliding_block_cached__glu_gated_bilinear__decode_kernel:
    s_cmp_ge_u32 s2, 256
    s_cbranch_scc1 L_end
    s_load_dwordx16 s[16:31], s[0:1], 0
    s_load_dwordx8 s[32:39], s[0:1], 64
    v_lshrrev_b32 v4, 6, v0
    v_and_b32 v1, 63, v0
    v_readfirstlane_b32 s3, v4
    v_lshrrev_b32 v2, 4, v1
    v_and_b32 v3, 15, v1
    s_mov_b32 s72, 0x05040100
    s_mov_b32 s73, 0x07060302
    s_mov_b32 s91, 0x3fb8aa3b
    s_waitcnt lgkmcnt(0)
    s_mov_b32 s40, s16
    s_mov_b32 s41, s17
    s_mov_b32 s42, 8192
    s_mov_b32 s43, 0x00020000
    s_mov_b32 s44, s18
    s_mov_b32 s45, s19
    s_mov_b32 s46, 67108864
    s_mov_b32 s47, 0x00020000
    s_mov_b32 s48, s20
    s_mov_b32 s49, s21
    s_mov_b32 s50, 67108864
    s_mov_b32 s51, 0x00020000
    s_mov_b32 s60, s38
    s_mov_b32 s61, s39
    s_mov_b32 s62, 268435456
    s_mov_b32 s63, 0x00020000
    s_mov_b32 s64, s36
    s_mov_b32 s65, s37
    s_mov_b32 s66, 256
    s_mov_b32 s67, 0x00020000
    s_mov_b32 s68, s34
    s_mov_b32 s69, s35
    s_mov_b32 s70, 8192
    s_mov_b32 s71, 0x00020000
    s_mov_b32 s52, s22
    s_mov_b32 s53, s23
    s_mov_b32 s54, 0x400000
    s_mov_b32 s55, 0x00020000
    s_mov_b32 s75, 8192
    s_mov_b32 s81, s2
    s_mov_b32 s82, 0
    s_cmp_lt_u32 s2, 128
    s_cbranch_scc1 L_p1sel
    s_mov_b32 s52, s28
    s_mov_b32 s53, s29
    s_mov_b32 s54, 1835008
    s_mov_b32 s75, 3584
    s_sub_u32 s81, s2, 128
    s_mov_b32 s82, 4096
    s_cmp_lt_u32 s2, 184
    s_cbranch_scc1 L_p1sel
    s_mov_b32 s52, s30
    s_mov_b32 s53, s31
    s_sub_u32 s81, s2, 184
    s_mov_b32 s82, 5888
L_p1sel:
    s_lshr_b32 s83, s81, 2
    s_and_b32 s84, s81, 3
    s_lshl_b32 s85, s84, 7
    s_lshl_b32 s86, s3, 5
    s_add_u32 s85, s85, s86
    s_mul_i32 s74, s85, s75
    s_lshl_b32 s86, s83, 8
    s_add_u32 s74, s74, s86
    s_lshl_b32 s93, s85, 1
    s_mul_i32 s76, s84, 61440
    s_add_u32 s76, s76, s82
    s_lshl_b32 s86, s83, 7
    s_add_u32 s76, s76, s86
    s_lshl_b32 s76, s76, 2
    s_cmp_lt_u32 s2, 240
    s_cselect_b32 s74, s74, 1073741824
    s_cselect_b32 s76, s76, 1073741824
    s_lshr_b32 s77, s2, 2
    s_lshl_b32 s77, s77, 20
    s_add_u32 s77, s77, 786432
    s_and_b32 s81, s2, 3
    s_lshl_b32 s81, s81, 16
    s_add_u32 s77, s77, s81
    s_lshl_b32 s81, s3, 14
    s_add_u32 s77, s77, s81
    s_lshl_b32 s92, s2, 12
    s_add_u32 s92, s92, 1048576
    s_lshr_b32 s81, s2, 5
    s_mul_i32 s87, s81, 7680
    s_lshr_b32 s81, s2, 2
    s_and_b32 s81, s81, 7
    s_lshl_b32 s81, s81, 9
    s_add_u32 s87, s87, s81
    s_lshl_b32 s87, s87, 2
    s_sub_u32 s81, 255, s2
    s_mov_b32 s56, s24
    s_mov_b32 s57, s25
    s_mov_b32 s58, 0x400000
    s_mov_b32 s59, 0x00020000
    s_mov_b32 s79, 1
    s_mov_b32 s82, s81
    s_cmp_lt_u32 s81, 128
    s_cbranch_scc1 L_p3sel
    s_mov_b32 s56, s32
    s_mov_b32 s57, s33
    s_mov_b32 s58, 1835008
    s_mov_b32 s79, 2
    s_sub_u32 s82, s81, 128
    s_cmp_lt_u32 s81, 184
    s_cbranch_scc1 L_p3sel
    s_mov_b32 s79, 0
L_p3sel:
    s_lshr_b32 s83, s82, 2
    s_and_b32 s84, s82, 3
    s_lshl_b32 s85, s83, 7
    s_lshl_b32 s86, s3, 5
    s_add_u32 s85, s85, s86
    s_lshl_b32 s78, s85, 10
    s_lshl_b32 s86, s84, 8
    s_add_u32 s78, s78, s86
    s_lshr_b32 s86, s81, 2
    s_lshl_b32 s80, s86, 14
    s_lshl_b32 s86, s84, 9
    s_add_u32 s80, s80, s86
    s_add_u32 s80, s80, 2097152
    s_add_u32 s88, s85, 4096
    s_lshl_b32 s88, s88, 2
    s_lshr_b32 s86, s83, 2
    s_lshl_b32 s89, s86, 14
    s_and_b32 s86, s83, 3
    s_lshl_b32 s86, s86, 9
    s_add_u32 s89, s89, s86
    s_lshl_b32 s86, s3, 7
    s_add_u32 s89, s89, s86
    s_add_u32 s89, s89, 1048576
    s_lshr_b32 s86, s83, 2
    s_lshl_b32 s98, s86, 14
    s_and_b32 s86, s83, 3
    s_lshl_b32 s86, s86, 3
    s_add_u32 s98, s98, s86
    s_add_u32 s98, s98, 1050624
    s_cmp_eq_u32 s79, 0
    s_cselect_b32 s78, 1073741824, s78
    s_cselect_b32 s80, 1073741824, s80
    s_cmp_eq_u32 s79, 2
    s_cselect_b32 s88, s88, 1073741824
    v_lshrrev_b32 v5, 5, v0
    v_and_b32 v6, 31, v0
    v_lshlrev_b32 v6, 4, v6
    v_mul_u32_u24 v4, 30720, v5
    v_add_u32 v4, v4, v6
    v_lshlrev_b32 v5, 11, v5
    v_add_u32 v5, v5, v6
    v_lshlrev_b32 v6, 4, v0
    v_mov_b32 v7, 1073741824
    v_cmp_gt_u32 vcc, 130, v0
    s_nop 1
    v_cndmask_b32 v6, v7, v6, vcc
    v_mov_b32 v14, 0
    ds_write_b32 v14, v14 offset:51200
    v_mov_b32 v192, -1
    v_mov_b32 v193, -1
    v_mov_b32 v194, -1
    v_mov_b32 v195, -1
    buffer_store_dwordx4 v[192:195], v4, s[60:63], s76 offen sc1
    buffer_store_dwordx4 v[192:195], v5, s[60:63], s80 offen sc1
    buffer_store_dwordx4 v[192:195], v6, s[60:63], s92 offen sc1
    v_lshlrev_b32 v7, 5, v0
    buffer_load_dwordx4 v[112:115], v7, s[40:43], 0 offen
    buffer_load_dwordx4 v[116:119], v7, s[40:43], 0 offen offset:16
    v_lshlrev_b32 v8, 3, v2
    v_mul_lo_u32 v8, v8, s75
    v_lshlrev_b32 v9, 4, v3
    v_add_u32 v8, v8, v9
    v_lshlrev_b32 v9, 8, v3
    v_lshl_add_u32 v9, v2, 4, v9
    v_lshlrev_b32 v10, 10, v2
    v_lshl_add_u32 v10, v3, 4, v10
    s_cmp_eq_u32 s79, 2
    s_cselect_b32 s81, 13, 11
    v_lshlrev_b32 v11, s81, v2
    v_lshl_add_u32 v11, v3, 4, v11
    s_mov_b32 s86, s74
    buffer_load_dwordx4 v[16:19], v8, s[52:55], s86 offen nt
    s_add_u32 s86, s86, s75
    buffer_load_dwordx4 v[20:23], v8, s[52:55], s86 offen nt
    s_add_u32 s86, s86, s75
    buffer_load_dwordx4 v[24:27], v8, s[52:55], s86 offen nt
    s_add_u32 s86, s86, s75
    buffer_load_dwordx4 v[28:31], v8, s[52:55], s86 offen nt
    s_add_u32 s86, s86, s75
    buffer_load_dwordx4 v[32:35], v8, s[52:55], s86 offen nt
    s_add_u32 s86, s86, s75
    buffer_load_dwordx4 v[36:39], v8, s[52:55], s86 offen nt
    s_add_u32 s86, s86, s75
    buffer_load_dwordx4 v[40:43], v8, s[52:55], s86 offen nt
    s_add_u32 s86, s86, s75
    buffer_load_dwordx4 v[44:47], v8, s[52:55], s86 offen nt
    s_waitcnt vmcnt(10)
    s_barrier
    s_cmp_lg_u32 s3, 0
    s_cbranch_scc1 L_noflag
    s_and_b32 s81, s2, 63
    s_lshl_b32 s81, s81, 2
    v_mov_b32 v14, s81
    v_mov_b32 v15, 1
    s_mov_b64 exec, 1
    buffer_atomic_add v15, v14, s[64:67], 0 offen sc1
    s_mov_b64 exec, -1
L_noflag:
    s_waitcnt vmcnt(8)
    v_lshlrev_b32 v120, 16, v112
    v_and_b32 v121, 0xffff0000, v112
    v_lshlrev_b32 v122, 16, v113
    v_and_b32 v123, 0xffff0000, v113
    v_lshlrev_b32 v124, 16, v114
    v_and_b32 v125, 0xffff0000, v114
    v_lshlrev_b32 v126, 16, v115
    v_and_b32 v127, 0xffff0000, v115
    v_lshlrev_b32 v128, 16, v116
    v_and_b32 v129, 0xffff0000, v116
    v_lshlrev_b32 v130, 16, v117
    v_and_b32 v131, 0xffff0000, v117
    v_lshlrev_b32 v132, 16, v118
    v_and_b32 v133, 0xffff0000, v118
    v_lshlrev_b32 v134, 16, v119
    v_and_b32 v135, 0xffff0000, v119
    v_add_f32 v136, v120, v121
    v_add_f32 v136, v136, v122
    v_add_f32 v136, v136, v123
    v_add_f32 v136, v136, v124
    v_add_f32 v136, v136, v125
    v_add_f32 v136, v136, v126
    v_add_f32 v136, v136, v127
    v_add_f32 v136, v136, v128
    v_add_f32 v136, v136, v129
    v_add_f32 v136, v136, v130
    v_add_f32 v136, v136, v131
    v_add_f32 v136, v136, v132
    v_add_f32 v136, v136, v133
    v_add_f32 v136, v136, v134
    v_add_f32 v136, v136, v135
    s_nop 1
    v_add_f32_dpp v136, v136, v136 quad_perm:[1,0,3,2] row_mask:0xf bank_mask:0xf
    s_nop 1
    v_add_f32_dpp v136, v136, v136 quad_perm:[2,3,0,1] row_mask:0xf bank_mask:0xf
    s_nop 1
    v_add_f32_dpp v136, v136, v136 row_half_mirror row_mask:0xf bank_mask:0xf
    s_nop 1
    v_add_f32_dpp v136, v136, v136 row_mirror row_mask:0xf bank_mask:0xf
    ds_swizzle_b32 v137, v136 offset:0x401F
    s_waitcnt lgkmcnt(0)
    v_add_f32 v136, v136, v137
    v_mul_f32 v136, 0x3b000000, v136
    s_waitcnt vmcnt(7)
    s_add_u32 s85, s77, 0
    buffer_load_dwordx4 a[0:3], v9, s[44:47], s85 offen offset:0 nt
    v_mov_b32 v138, 0
    v_sub_f32 v139, v120, v136
    v_fmac_f32 v138, v139, v139
    v_sub_f32 v139, v121, v136
    v_fmac_f32 v138, v139, v139
    v_sub_f32 v139, v122, v136
    v_fmac_f32 v138, v139, v139
    v_sub_f32 v139, v123, v136
    v_fmac_f32 v138, v139, v139
    v_sub_f32 v139, v124, v136
    v_fmac_f32 v138, v139, v139
    v_sub_f32 v139, v125, v136
    v_fmac_f32 v138, v139, v139
    v_sub_f32 v139, v126, v136
    v_fmac_f32 v138, v139, v139
    v_sub_f32 v139, v127, v136
    v_fmac_f32 v138, v139, v139
    v_sub_f32 v139, v128, v136
    v_fmac_f32 v138, v139, v139
    v_sub_f32 v139, v129, v136
    v_fmac_f32 v138, v139, v139
    v_sub_f32 v139, v130, v136
    v_fmac_f32 v138, v139, v139
    v_sub_f32 v139, v131, v136
    v_fmac_f32 v138, v139, v139
    v_sub_f32 v139, v132, v136
    v_fmac_f32 v138, v139, v139
    v_sub_f32 v139, v133, v136
    v_fmac_f32 v138, v139, v139
    v_sub_f32 v139, v134, v136
    v_fmac_f32 v138, v139, v139
    v_sub_f32 v139, v135, v136
    v_fmac_f32 v138, v139, v139
    s_nop 1
    v_add_f32_dpp v138, v138, v138 quad_perm:[1,0,3,2] row_mask:0xf bank_mask:0xf
    s_nop 1
    v_add_f32_dpp v138, v138, v138 quad_perm:[2,3,0,1] row_mask:0xf bank_mask:0xf
    s_nop 1
    v_add_f32_dpp v138, v138, v138 row_half_mirror row_mask:0xf bank_mask:0xf
    s_nop 1
    v_add_f32_dpp v138, v138, v138 row_mirror row_mask:0xf bank_mask:0xf
    ds_swizzle_b32 v137, v138 offset:0x401F
    s_waitcnt lgkmcnt(0)
    v_add_f32 v138, v138, v137
    v_mul_f32 v138, 0x3b000000, v138
    s_waitcnt vmcnt(7)
    buffer_load_dwordx4 a[4:7], v9, s[44:47], s85 offen offset:64 nt
    v_cvt_pk_bf16_f32 v139, v136, v138
    v_lshlrev_b32 v136, 16, v139
    v_and_b32 v138, 0xffff0000, v139
    v_add_f32 v138, 0x3727c5ac, v138
    v_cvt_pk_bf16_f32 v138, v138, v138
    v_lshlrev_b32 v138, 16, v138
    v_sqrt_f32 v138, v138
    s_nop 0
    v_cvt_pk_bf16_f32 v138, v138, v138
    v_lshlrev_b32 v138, 16, v138
    v_rcp_f32 v139, v138
    v_sub_f32 v120, v120, v136
    v_sub_f32 v121, v121, v136
    v_sub_f32 v122, v122, v136
    v_sub_f32 v123, v123, v136
    v_sub_f32 v124, v124, v136
    v_sub_f32 v125, v125, v136
    v_sub_f32 v126, v126, v136
    v_sub_f32 v127, v127, v136
    v_sub_f32 v128, v128, v136
    v_sub_f32 v129, v129, v136
    v_sub_f32 v130, v130, v136
    v_sub_f32 v131, v131, v136
    v_sub_f32 v132, v132, v136
    v_sub_f32 v133, v133, v136
    v_sub_f32 v134, v134, v136
    v_sub_f32 v135, v135, v136
    v_cvt_pk_bf16_f32 v112, v120, v121
    v_cvt_pk_bf16_f32 v113, v122, v123
    v_cvt_pk_bf16_f32 v114, v124, v125
    v_cvt_pk_bf16_f32 v115, v126, v127
    v_cvt_pk_bf16_f32 v116, v128, v129
    v_cvt_pk_bf16_f32 v117, v130, v131
    v_cvt_pk_bf16_f32 v118, v132, v133
    v_cvt_pk_bf16_f32 v119, v134, v135
    v_lshlrev_b32 v120, 16, v112
    v_and_b32 v121, 0xffff0000, v112
    v_lshlrev_b32 v122, 16, v113
    v_and_b32 v123, 0xffff0000, v113
    v_lshlrev_b32 v124, 16, v114
    v_and_b32 v125, 0xffff0000, v114
    v_lshlrev_b32 v126, 16, v115
    v_and_b32 v127, 0xffff0000, v115
    v_lshlrev_b32 v128, 16, v116
    v_and_b32 v129, 0xffff0000, v116
    v_lshlrev_b32 v130, 16, v117
    v_and_b32 v131, 0xffff0000, v117
    v_lshlrev_b32 v132, 16, v118
    v_and_b32 v133, 0xffff0000, v118
    v_lshlrev_b32 v134, 16, v119
    v_and_b32 v135, 0xffff0000, v119
    v_mul_f32 v140, v120, v139
    v_fma_f32 v141, -v140, v138, v120
    v_fma_f32 v120, v141, v139, v140
    v_mul_f32 v140, v121, v139
    v_fma_f32 v141, -v140, v138, v121
    v_fma_f32 v121, v141, v139, v140
    v_mul_f32 v140, v122, v139
    v_fma_f32 v141, -v140, v138, v122
    v_fma_f32 v122, v141, v139, v140
    v_mul_f32 v140, v123, v139
    v_fma_f32 v141, -v140, v138, v123
    v_fma_f32 v123, v141, v139, v140
    v_mul_f32 v140, v124, v139
    v_fma_f32 v141, -v140, v138, v124
    v_fma_f32 v124, v141, v139, v140
    v_mul_f32 v140, v125, v139
    v_fma_f32 v141, -v140, v138, v125
    v_fma_f32 v125, v141, v139, v140
    v_mul_f32 v140, v126, v139
    v_fma_f32 v141, -v140, v138, v126
    v_fma_f32 v126, v141, v139, v140
    v_mul_f32 v140, v127, v139
    v_fma_f32 v141, -v140, v138, v127
    v_fma_f32 v127, v141, v139, v140
    v_mul_f32 v140, v128, v139
    v_fma_f32 v141, -v140, v138, v128
    v_fma_f32 v128, v141, v139, v140
    v_mul_f32 v140, v129, v139
    v_fma_f32 v141, -v140, v138, v129
    v_fma_f32 v129, v141, v139, v140
    v_mul_f32 v140, v130, v139
    v_fma_f32 v141, -v140, v138, v130
    v_fma_f32 v130, v141, v139, v140
    v_mul_f32 v140, v131, v139
    v_fma_f32 v141, -v140, v138, v131
    v_fma_f32 v131, v141, v139, v140
    v_mul_f32 v140, v132, v139
    v_fma_f32 v141, -v140, v138, v132
    v_fma_f32 v132, v141, v139, v140
    v_mul_f32 v140, v133, v139
    v_fma_f32 v141, -v140, v138, v133
    v_fma_f32 v133, v141, v139, v140
    v_mul_f32 v140, v134, v139
    v_fma_f32 v141, -v140, v138, v134
    v_fma_f32 v134, v141, v139, v140
    v_mul_f32 v140, v135, v139
    v_fma_f32 v141, -v140, v138, v135
    v_fma_f32 v135, v141, v139, v140
    v_cvt_pk_bf16_f32 v112, v120, v121
    v_cvt_pk_bf16_f32 v113, v122, v123
    v_cvt_pk_bf16_f32 v114, v124, v125
    v_cvt_pk_bf16_f32 v115, v126, v127
    v_cvt_pk_bf16_f32 v116, v128, v129
    v_cvt_pk_bf16_f32 v117, v130, v131
    v_cvt_pk_bf16_f32 v118, v132, v133
    v_cvt_pk_bf16_f32 v119, v134, v135
    s_waitcnt vmcnt(7)
    buffer_load_dwordx4 a[8:11], v9, s[44:47], s85 offen offset:128 nt
    ds_write_b128 v7, v[112:115] offset:0
    ds_write_b128 v7, v[116:119] offset:16
    s_waitcnt lgkmcnt(0)
    s_barrier
    v_and_b32 v12, 7, v3
    v_lshlrev_b32 v12, 10, v12
    v_lshl_add_u32 v12, v2, 4, v12
    v_add_u32 v12, s93, v12
    ds_read_b128 v[248:251], v12 offset:0
    s_waitcnt vmcnt(7)
    buffer_load_dwordx4 a[12:15], v9, s[44:47], s85 offen offset:192 nt
    s_waitcnt vmcnt(7)
    s_add_u32 s85, s77, 4096
    buffer_load_dwordx4 a[16:19], v9, s[44:47], s85 offen offset:0 nt
    s_waitcnt vmcnt(7)
    buffer_load_dwordx4 a[20:23], v9, s[44:47], s85 offen offset:64 nt
    s_waitcnt vmcnt(7)
    buffer_load_dwordx4 a[24:27], v9, s[44:47], s85 offen offset:128 nt
    s_waitcnt vmcnt(7)
    buffer_load_dwordx4 a[28:31], v9, s[44:47], s85 offen offset:192 nt
    v_perm_b32 v112, v20, v16, s72
    v_perm_b32 v113, v28, v24, s72
    v_perm_b32 v114, v36, v32, s72
    v_perm_b32 v115, v44, v40, s72
    v_perm_b32 v116, v20, v16, s73
    v_perm_b32 v117, v28, v24, s73
    v_perm_b32 v118, v36, v32, s73
    v_perm_b32 v119, v44, v40, s73
    v_perm_b32 v120, v21, v17, s72
    v_perm_b32 v121, v29, v25, s72
    v_perm_b32 v122, v37, v33, s72
    v_perm_b32 v123, v45, v41, s72
    v_perm_b32 v124, v21, v17, s73
    v_perm_b32 v125, v29, v25, s73
    v_perm_b32 v126, v37, v33, s73
    v_perm_b32 v127, v45, v41, s73
    v_perm_b32 v128, v22, v18, s72
    v_perm_b32 v129, v30, v26, s72
    v_perm_b32 v130, v38, v34, s72
    v_perm_b32 v131, v46, v42, s72
    v_perm_b32 v132, v22, v18, s73
    v_perm_b32 v133, v30, v26, s73
    v_perm_b32 v134, v38, v34, s73
    v_perm_b32 v135, v46, v42, s73
    v_perm_b32 v136, v23, v19, s72
    v_perm_b32 v137, v31, v27, s72
    v_perm_b32 v138, v39, v35, s72
    v_perm_b32 v139, v47, v43, s72
    v_perm_b32 v140, v23, v19, s73
    v_perm_b32 v141, v31, v27, s73
    v_perm_b32 v142, v39, v35, s73
    v_perm_b32 v143, v47, v43, s73
    s_waitcnt lgkmcnt(0)
    s_nop 1
    v_mfma_f32_16x16x32_bf16 v[144:147], v[112:115], v[248:251], 0
    v_mfma_f32_16x16x32_bf16 v[148:151], v[116:119], v[248:251], 0
    v_mfma_f32_16x16x32_bf16 v[152:155], v[120:123], v[248:251], 0
    v_mfma_f32_16x16x32_bf16 v[156:159], v[124:127], v[248:251], 0
    v_mfma_f32_16x16x32_bf16 v[160:163], v[128:131], v[248:251], 0
    v_mfma_f32_16x16x32_bf16 v[164:167], v[132:135], v[248:251], 0
    v_mfma_f32_16x16x32_bf16 v[168:171], v[136:139], v[248:251], 0
    v_mfma_f32_16x16x32_bf16 v[172:175], v[140:143], v[248:251], 0
    v_and_b32 v12, 7, v3
    v_lshlrev_b32 v12, 9, v12
    v_lshl_add_u32 v12, v2, 7, v12
    s_lshl_b32 s81, s3, 12
    v_add_u32 v12, s81, v12
    v_cmp_gt_u32 vcc, 8, v3
    s_nop 4
    s_and_saveexec_b64 s[96:97], vcc
    ds_write_b128 v12, v[144:147] offset:8192
    ds_write_b128 v12, v[148:151] offset:8208
    ds_write_b128 v12, v[152:155] offset:8224
    ds_write_b128 v12, v[156:159] offset:8240
    ds_write_b128 v12, v[160:163] offset:8256
    ds_write_b128 v12, v[164:167] offset:8272
    ds_write_b128 v12, v[168:171] offset:8288
    ds_write_b128 v12, v[172:175] offset:8304
    s_mov_b64 exec, s[96:97]
    s_waitcnt vmcnt(7)
    s_add_u32 s85, s77, 8192
    buffer_load_dwordx4 a[32:35], v9, s[44:47], s85 offen offset:0 nt
    s_waitcnt lgkmcnt(0)
    s_barrier
    v_lshrrev_b32 v12, 5, v0
    v_lshlrev_b32 v12, 9, v12
    v_bfe_u32 v14, v0, 3, 2
    v_lshl_add_u32 v12, v14, 7, v12
    v_and_b32 v14, 1, v0
    v_lshl_add_u32 v12, v14, 6, v12
    v_bfe_u32 v14, v0, 1, 2
    v_lshl_add_u32 v12, v14, 2, v12
    v_add_u32 v12, 8192, v12
    ds_read2_b32 v[112:113], v12 offset0:0 offset1:4
    ds_read2_b32 v[114:115], v12 offset0:8 offset1:12
    v_add_u32 v12, 0x1000, v12
    ds_read2_b32 v[116:117], v12 offset0:0 offset1:4
    ds_read2_b32 v[118:119], v12 offset0:8 offset1:12
    v_add_u32 v12, 0x1000, v12
    ds_read2_b32 v[120:121], v12 offset0:0 offset1:4
    ds_read2_b32 v[122:123], v12 offset0:8 offset1:12
    v_add_u32 v12, 0x1000, v12
    ds_read2_b32 v[124:125], v12 offset0:0 offset1:4
    ds_read2_b32 v[126:127], v12 offset0:8 offset1:12
    s_waitcnt lgkmcnt(0)
    v_add_f32 v112, v112, v116
    v_add_f32 v120, v120, v124
    v_add_f32 v113, v113, v117
    v_add_f32 v121, v121, v125
    v_add_f32 v114, v114, v118
    v_add_f32 v122, v122, v126
    v_add_f32 v115, v115, v119
    v_add_f32 v123, v123, v127
    v_add_f32 v112, v112, v120
    v_add_f32 v113, v113, v121
    v_add_f32 v114, v114, v122
    v_add_f32 v115, v115, v123
    v_min_u32 v112, -2, v112
    v_min_u32 v113, -2, v113
    v_min_u32 v114, -2, v114
    v_min_u32 v115, -2, v115
    buffer_store_dwordx4 v[112:115], v4, s[60:63], s76 offen sc1
    v_lshlrev_b32 v12, 3, v0
    v_and_b32 v14, 7, v3
    v_mul_u32_u24 v14, 30720, v14
    v_lshrrev_b32 v15, 3, v3
    v_mul_u32_u24 v15, 7168, v15
    v_add_u32 v14, v14, v15
    v_lshl_add_u32 v14, v2, 5, v14
    v_mov_b32 v252, v14
    v_lshlrev_b32 v253, 2, v1
    s_waitcnt vmcnt(8)
    buffer_load_dwordx4 a[36:39], v9, s[44:47], s85 offen offset:64 nt
    s_waitcnt vmcnt(8)
    buffer_load_dwordx4 a[40:43], v9, s[44:47], s85 offen offset:128 nt
    s_waitcnt vmcnt(8)
    buffer_load_dwordx4 a[44:47], v9, s[44:47], s85 offen offset:192 nt
    s_waitcnt vmcnt(8)
    s_add_u32 s85, s77, 12288
    buffer_load_dwordx4 a[48:51], v9, s[44:47], s85 offen offset:0 nt
    s_cmp_eq_u32 s3, 0
    s_cbranch_scc1 L_w0seg
    s_waitcnt vmcnt(8)
    buffer_load_dwordx4 a[52:55], v9, s[44:47], s85 offen offset:64 nt
    s_waitcnt vmcnt(8)
    buffer_load_dwordx4 a[56:59], v9, s[44:47], s85 offen offset:128 nt
    s_waitcnt vmcnt(8)
    buffer_load_dwordx4 a[60:63], v9, s[44:47], s85 offen offset:192 nt
    s_waitcnt vmcnt(8)
    s_add_u32 s84, s77, 0
    buffer_load_dwordx4 v[48:51], v10, s[48:51], s84 offen offset:0 nt
    s_waitcnt vmcnt(7)
    buffer_load_dwordx4 v[52:55], v10, s[48:51], s84 offen offset:256 nt
    s_waitcnt vmcnt(7)
    buffer_load_dwordx4 v[56:59], v10, s[48:51], s84 offen offset:512 nt
    s_waitcnt vmcnt(7)
    buffer_load_dwordx4 v[60:63], v10, s[48:51], s84 offen offset:768 nt
    s_waitcnt vmcnt(7)
    s_add_u32 s84, s77, 4096
    buffer_load_dwordx4 v[64:67], v10, s[48:51], s84 offen offset:0 nt
    s_waitcnt vmcnt(7)
    buffer_load_dwordx4 v[68:71], v10, s[48:51], s84 offen offset:256 nt
    s_branch L_segjoin
L_w0seg:
    s_waitcnt vmcnt(8)
    buffer_load_dwordx4 a[52:55], v9, s[44:47], s85 offen offset:64 nt
    buffer_load_dword v254, v253, s[64:67], 0 offen sc1
    s_waitcnt vmcnt(9)
    buffer_load_dwordx4 a[56:59], v9, s[44:47], s85 offen offset:128 nt
    s_waitcnt vmcnt(9)
    buffer_load_dwordx4 a[60:63], v9, s[44:47], s85 offen offset:192 nt
    s_waitcnt vmcnt(9)
    s_add_u32 s84, s77, 0
    buffer_load_dwordx4 v[48:51], v10, s[48:51], s84 offen offset:0 nt
    s_waitcnt vmcnt(8)
    buffer_load_dwordx4 v[52:55], v10, s[48:51], s84 offen offset:256 nt
    s_waitcnt vmcnt(8)
    buffer_load_dwordx4 v[56:59], v10, s[48:51], s84 offen offset:512 nt
    s_waitcnt vmcnt(8)
    buffer_load_dwordx4 v[60:63], v10, s[48:51], s84 offen offset:768 nt
    s_waitcnt vmcnt(8)
    s_add_u32 s84, s77, 4096
    buffer_load_dwordx4 v[64:67], v10, s[48:51], s84 offen offset:0 nt
    s_waitcnt vmcnt(8)
    buffer_load_dwordx4 v[68:71], v10, s[48:51], s84 offen offset:256 nt
    s_waitcnt vmcnt(8)
    s_mov_b32 s90, 0
L_fl_chk:
    v_cmp_eq_u32 vcc, 4, v254
    s_cmp_eq_u64 vcc, -1
    s_cbranch_scc1 L_fl_ok
    s_add_u32 s90, s90, 1
    s_cmp_gt_u32 s90, 20000
    s_cbranch_scc1 L_fl_ok
    buffer_load_dword v254, v253, s[64:67], 0 offen sc1
    s_waitcnt vmcnt(0)
    s_branch L_fl_chk
L_fl_ok:
    v_mov_b32 v14, 0
    v_mov_b32 v15, 1
    ds_write_b32 v14, v15 offset:51200
L_segjoin:
    s_waitcnt vmcnt(7)
    buffer_load_dwordx4 v[72:75], v10, s[48:51], s84 offen offset:512 nt
    s_mov_b32 s90, 0
    v_mov_b32 v14, 0
L_lf_chk:
    ds_read_b32 v15, v14 offset:51200
    s_waitcnt lgkmcnt(0)
    v_cmp_eq_u32 vcc, 1, v15
    s_cmp_eq_u64 vcc, -1
    s_cbranch_scc1 L_lf_ok
    s_add_u32 s90, s90, 1
    s_cmp_gt_u32 s90, 4000000
    s_cbranch_scc0 L_lf_chk
L_lf_ok:
    s_add_u32 s82, s87, 0
    buffer_load_dwordx2 v[112:113], v12, s[60:63], s82 offen sc1
    s_add_u32 s82, s87, 245760
    buffer_load_dwordx2 v[114:115], v12, s[60:63], s82 offen sc1
    s_add_u32 s82, s87, 491520
    buffer_load_dwordx2 v[116:117], v12, s[60:63], s82 offen sc1
    s_add_u32 s82, s87, 737280
    buffer_load_dwordx2 v[118:119], v12, s[60:63], s82 offen sc1
    s_waitcnt vmcnt(11)
    buffer_load_dwordx4 v[76:79], v10, s[48:51], s84 offen offset:768 nt
    s_waitcnt vmcnt(11)
    s_add_u32 s84, s77, 8192
    buffer_load_dwordx4 v[80:83], v10, s[48:51], s84 offen offset:0 nt
    s_waitcnt vmcnt(11)
    buffer_load_dwordx4 v[84:87], v10, s[48:51], s84 offen offset:256 nt
    s_waitcnt vmcnt(11)
    buffer_load_dwordx4 v[88:91], v10, s[48:51], s84 offen offset:512 nt
    s_waitcnt vmcnt(11)
    buffer_load_dwordx4 v[92:95], v10, s[48:51], s84 offen offset:768 nt
    s_waitcnt vmcnt(11)
    s_add_u32 s84, s77, 12288
    buffer_load_dwordx4 v[96:99], v10, s[48:51], s84 offen offset:0 nt
    s_waitcnt vmcnt(11)
    buffer_load_dwordx4 v[100:103], v10, s[48:51], s84 offen offset:256 nt
    s_waitcnt vmcnt(11)
    buffer_load_dwordx4 v[104:107], v10, s[48:51], s84 offen offset:512 nt
    s_waitcnt vmcnt(7)
    buffer_load_dwordx4 v[108:111], v10, s[48:51], s84 offen offset:768 nt
    s_waitcnt vmcnt(9)
    s_mov_b32 s90, 0
L_g_chk:
    v_max3_u32 v14, v112, v113, v114
    v_max3_u32 v14, v14, v115, v116
    v_max3_u32 v14, v14, v117, v118
    v_max_u32 v14, v14, v119
    v_cmp_eq_u32 vcc, -1, v14
    s_cmp_eq_u64 vcc, 0
    s_cbranch_scc1 L_g_ok
    s_add_u32 s90, s90, 1
    s_cmp_gt_u32 s90, 20000
    s_cbranch_scc1 L_g_ok
    s_add_u32 s82, s87, 0
    buffer_load_dwordx2 v[112:113], v12, s[60:63], s82 offen sc1
    s_add_u32 s82, s87, 245760
    buffer_load_dwordx2 v[114:115], v12, s[60:63], s82 offen sc1
    s_add_u32 s82, s87, 491520
    buffer_load_dwordx2 v[116:117], v12, s[60:63], s82 offen sc1
    s_add_u32 s82, s87, 737280
    buffer_load_dwordx2 v[118:119], v12, s[60:63], s82 offen sc1
    s_waitcnt vmcnt(0)
    s_branch L_g_chk
L_g_ok:
    v_add_f32 v112, v112, v114
    v_add_f32 v116, v116, v118
    v_add_f32 v113, v113, v115
    v_add_f32 v117, v117, v119
    v_add_f32 v112, v112, v116
    v_add_f32 v113, v113, v117
    v_cvt_pk_bf16_f32 v112, v112, v113
    v_lshlrev_b32 v14, 2, v0
    ds_write_b32 v14, v112 offset:50176
    s_waitcnt lgkmcnt(0)
    s_barrier
    v_and_b32 v14, 3, v3
    v_lshlrev_b32 v14, 8, v14
    v_lshl_add_u32 v14, v2, 4, v14
    ds_read_b128 v[176:179], v14 offset:50176
    ds_read_b128 v[180:183], v14 offset:50240
    ds_read_b128 v[184:187], v14 offset:50304
    ds_read_b128 v[188:191], v14 offset:50368
    s_waitcnt lgkmcnt(0)
    v_mfma_f32_16x16x32_bf16 v[192:195], a[0:3], v[176:179], 0
    v_mfma_f32_16x16x32_bf16 v[192:195], a[4:7], v[180:183], v[192:195]
    v_mfma_f32_16x16x32_bf16 v[192:195], a[8:11], v[184:187], v[192:195]
    v_mfma_f32_16x16x32_bf16 v[192:195], a[12:15], v[188:191], v[192:195]
    v_mfma_f32_16x16x32_bf16 v[196:199], a[16:19], v[176:179], 0
    v_mfma_f32_16x16x32_bf16 v[196:199], a[20:23], v[180:183], v[196:199]
    v_mfma_f32_16x16x32_bf16 v[196:199], a[24:27], v[184:187], v[196:199]
    v_mfma_f32_16x16x32_bf16 v[196:199], a[28:31], v[188:191], v[196:199]
    v_mfma_f32_16x16x32_bf16 v[200:203], a[32:35], v[176:179], 0
    v_mfma_f32_16x16x32_bf16 v[200:203], a[36:39], v[180:183], v[200:203]
    v_mfma_f32_16x16x32_bf16 v[200:203], a[40:43], v[184:187], v[200:203]
    v_mfma_f32_16x16x32_bf16 v[200:203], a[44:47], v[188:191], v[200:203]
    v_mfma_f32_16x16x32_bf16 v[204:207], a[48:51], v[176:179], 0
    v_mfma_f32_16x16x32_bf16 v[204:207], a[52:55], v[180:183], v[204:207]
    v_mfma_f32_16x16x32_bf16 v[204:207], a[56:59], v[184:187], v[204:207]
    v_mfma_f32_16x16x32_bf16 v[204:207], a[60:63], v[188:191], v[204:207]
    s_nop 7
    s_nop 1
    s_mov_b32 s81, 0x3db504f3
    v_cvt_pk_bf16_f32 v112, v192, v193
    v_cvt_pk_bf16_f32 v113, v194, v195
    v_cvt_pk_bf16_f32 v114, v196, v197
    v_cvt_pk_bf16_f32 v115, v198, v199
    v_cvt_pk_bf16_f32 v116, v200, v201
    v_cvt_pk_bf16_f32 v117, v202, v203
    v_cvt_pk_bf16_f32 v118, v204, v205
    v_cvt_pk_bf16_f32 v119, v206, v207
    v_lshlrev_b32 v192, 16, v112
    v_and_b32 v193, 0xffff0000, v112
    v_lshlrev_b32 v194, 16, v113
    v_and_b32 v195, 0xffff0000, v113
    v_lshlrev_b32 v196, 16, v114
    v_and_b32 v197, 0xffff0000, v114
    v_lshlrev_b32 v198, 16, v115
    v_and_b32 v199, 0xffff0000, v115
    v_lshlrev_b32 v200, 16, v116
    v_and_b32 v201, 0xffff0000, v116
    v_lshlrev_b32 v202, 16, v117
    v_and_b32 v203, 0xffff0000, v117
    v_lshlrev_b32 v204, 16, v118
    v_and_b32 v205, 0xffff0000, v118
    v_lshlrev_b32 v206, 16, v119
    v_and_b32 v207, 0xffff0000, v119
    v_mul_f32 v192, s81, v192
    v_mul_f32 v193, s81, v193
    v_mul_f32 v194, s81, v194
    v_mul_f32 v195, s81, v195
    v_mul_f32 v196, s81, v196
    v_mul_f32 v197, s81, v197
    v_mul_f32 v198, s81, v198
    v_mul_f32 v199, s81, v199
    v_mul_f32 v200, s81, v200
    v_mul_f32 v201, s81, v201
    v_mul_f32 v202, s81, v202
    v_mul_f32 v203, s81, v203
    v_mul_f32 v204, s81, v204
    v_mul_f32 v205, s81, v205
    v_mul_f32 v206, s81, v206
    v_mul_f32 v207, s81, v207
    v_cvt_pk_bf16_f32 v112, v192, v193
    v_cvt_pk_bf16_f32 v113, v194, v195
    v_cvt_pk_bf16_f32 v114, v196, v197
    v_cvt_pk_bf16_f32 v115, v198, v199
    v_cvt_pk_bf16_f32 v116, v200, v201
    v_cvt_pk_bf16_f32 v117, v202, v203
    v_cvt_pk_bf16_f32 v118, v204, v205
    v_cvt_pk_bf16_f32 v119, v206, v207
    v_lshlrev_b32 v192, 16, v112
    v_and_b32 v193, 0xffff0000, v112
    v_lshlrev_b32 v194, 16, v113
    v_and_b32 v195, 0xffff0000, v113
    v_lshlrev_b32 v196, 16, v114
    v_and_b32 v197, 0xffff0000, v114
    v_lshlrev_b32 v198, 16, v115
    v_and_b32 v199, 0xffff0000, v115
    v_lshlrev_b32 v200, 16, v116
    v_and_b32 v201, 0xffff0000, v116
    v_lshlrev_b32 v202, 16, v117
    v_and_b32 v203, 0xffff0000, v117
    v_lshlrev_b32 v204, 16, v118
    v_and_b32 v205, 0xffff0000, v118
    v_lshlrev_b32 v206, 16, v119
    v_and_b32 v207, 0xffff0000, v119
    s_waitcnt vmcnt(7)
    s_cmp_eq_u32 s79, 2
    s_cselect_b32 s83, 0, 0
    s_lshl_b32 s83, s83, 10
    s_add_u32 s83, s83, s78
    buffer_load_dwordx4 v[16:19], v11, s[56:59], s83 offen nt
    v_max3_f32 v14, v192, v193, v194
    v_max3_f32 v14, v14, v195, v196
    v_max3_f32 v14, v14, v197, v198
    v_max3_f32 v14, v14, v199, v200
    v_max3_f32 v14, v14, v201, v202
    v_max3_f32 v14, v14, v203, v204
    v_max3_f32 v14, v14, v205, v206
    v_max_f32 v14, v14, v207
    v_and_b32 v15, 3, v3
    v_lshlrev_b32 v15, 6, v15
    v_lshl_add_u32 v255, v2, 2, v15
    s_lshl_b32 s81, s3, 4
    v_add_u32 v255, s81, v255
    ds_write_b32 v255, v14 offset:24576
    s_waitcnt lgkmcnt(0)
    s_barrier
    ds_read_b128 v[112:115], v15 offset:24576
    ds_read_b128 v[116:119], v15 offset:24592
    ds_read_b128 v[120:123], v15 offset:24608
    ds_read_b128 v[124:127], v15 offset:24624
    s_waitcnt lgkmcnt(0)
    v_max3_f32 v14, v112, v113, v114
    v_max3_f32 v14, v14, v115, v116
    v_max3_f32 v14, v14, v117, v118
    v_max3_f32 v14, v14, v119, v120
    v_max3_f32 v14, v14, v121, v122
    v_max3_f32 v14, v14, v123, v124
    v_max3_f32 v14, v14, v125, v126
    v_max_f32 v14, v14, v127
    v_sub_f32 v192, v192, v14
    v_sub_f32 v193, v193, v14
    v_sub_f32 v194, v194, v14
    v_sub_f32 v195, v195, v14
    v_sub_f32 v196, v196, v14
    v_sub_f32 v197, v197, v14
    v_sub_f32 v198, v198, v14
    v_sub_f32 v199, v199, v14
    v_sub_f32 v200, v200, v14
    v_sub_f32 v201, v201, v14
    v_sub_f32 v202, v202, v14
    v_sub_f32 v203, v203, v14
    v_sub_f32 v204, v204, v14
    v_sub_f32 v205, v205, v14
    v_sub_f32 v206, v206, v14
    v_sub_f32 v207, v207, v14
    v_mul_f32 v192, s91, v192
    v_mul_f32 v193, s91, v193
    v_mul_f32 v194, s91, v194
    v_mul_f32 v195, s91, v195
    v_mul_f32 v196, s91, v196
    v_mul_f32 v197, s91, v197
    v_mul_f32 v198, s91, v198
    v_mul_f32 v199, s91, v199
    v_mul_f32 v200, s91, v200
    v_mul_f32 v201, s91, v201
    v_mul_f32 v202, s91, v202
    v_mul_f32 v203, s91, v203
    v_mul_f32 v204, s91, v204
    v_mul_f32 v205, s91, v205
    v_mul_f32 v206, s91, v206
    v_mul_f32 v207, s91, v207
    v_exp_f32 v192, v192
    v_exp_f32 v193, v193
    v_exp_f32 v194, v194
    v_exp_f32 v195, v195
    v_exp_f32 v196, v196
    v_exp_f32 v197, v197
    v_exp_f32 v198, v198
    v_exp_f32 v199, v199
    v_exp_f32 v200, v200
    v_exp_f32 v201, v201
    v_exp_f32 v202, v202
    v_exp_f32 v203, v203
    v_exp_f32 v204, v204
    v_exp_f32 v205, v205
    v_exp_f32 v206, v206
    v_exp_f32 v207, v207
    s_nop 0
    v_add_f32 v14, v192, v193
    v_add_f32 v14, v14, v194
    v_add_f32 v14, v14, v195
    v_add_f32 v14, v14, v196
    v_add_f32 v14, v14, v197
    v_add_f32 v14, v14, v198
    v_add_f32 v14, v14, v199
    v_add_f32 v14, v14, v200
    v_add_f32 v14, v14, v201
    v_add_f32 v14, v14, v202
    v_add_f32 v14, v14, v203
    v_add_f32 v14, v14, v204
    v_add_f32 v14, v14, v205
    v_add_f32 v14, v14, v206
    v_add_f32 v14, v14, v207
    ds_write_b32 v255, v14 offset:24832
    v_cvt_pk_bf16_f32 v208, v192, v193
    v_cvt_pk_bf16_f32 v209, v194, v195
    v_cvt_pk_bf16_f32 v210, v196, v197
    v_cvt_pk_bf16_f32 v211, v198, v199
    v_cvt_pk_bf16_f32 v212, v200, v201
    v_cvt_pk_bf16_f32 v213, v202, v203
    v_cvt_pk_bf16_f32 v214, v204, v205
    v_cvt_pk_bf16_f32 v215, v206, v207
    v_perm_b32 v112, v52, v48, s72
    v_perm_b32 v113, v60, v56, s72
    v_perm_b32 v114, v68, v64, s72
    v_perm_b32 v115, v76, v72, s72
    v_perm_b32 v116, v52, v48, s73
    v_perm_b32 v117, v60, v56, s73
    v_perm_b32 v118, v68, v64, s73
    v_perm_b32 v119, v76, v72, s73
    v_perm_b32 v120, v53, v49, s72
    v_perm_b32 v121, v61, v57, s72
    v_perm_b32 v122, v69, v65, s72
    v_perm_b32 v123, v77, v73, s72
    v_perm_b32 v124, v53, v49, s73
    v_perm_b32 v125, v61, v57, s73
    v_perm_b32 v126, v69, v65, s73
    v_perm_b32 v127, v77, v73, s73
    v_perm_b32 v128, v54, v50, s72
    v_perm_b32 v129, v62, v58, s72
    v_perm_b32 v130, v70, v66, s72
    v_perm_b32 v131, v78, v74, s72
    v_perm_b32 v132, v54, v50, s73
    v_perm_b32 v133, v62, v58, s73
    v_perm_b32 v134, v70, v66, s73
    v_perm_b32 v135, v78, v74, s73
    v_perm_b32 v136, v55, v51, s72
    v_perm_b32 v137, v63, v59, s72
    v_perm_b32 v138, v71, v67, s72
    v_perm_b32 v139, v79, v75, s72
    v_perm_b32 v140, v55, v51, s73
    v_perm_b32 v141, v63, v59, s73
    v_perm_b32 v142, v71, v67, s73
    v_perm_b32 v143, v79, v75, s73
    s_nop 1
    v_mfma_f32_16x16x32_bf16 v[144:147], v[112:115], v[208:211], 0
    v_mfma_f32_16x16x32_bf16 v[148:151], v[116:119], v[208:211], 0
    v_mfma_f32_16x16x32_bf16 v[152:155], v[120:123], v[208:211], 0
    v_mfma_f32_16x16x32_bf16 v[156:159], v[124:127], v[208:211], 0
    v_mfma_f32_16x16x32_bf16 v[160:163], v[128:131], v[208:211], 0
    v_mfma_f32_16x16x32_bf16 v[164:167], v[132:135], v[208:211], 0
    v_mfma_f32_16x16x32_bf16 v[168:171], v[136:139], v[208:211], 0
    v_mfma_f32_16x16x32_bf16 v[172:175], v[140:143], v[208:211], 0
    s_waitcnt vmcnt(7)
    s_cmp_eq_u32 s79, 2
    s_cselect_b32 s83, 1, 8
    s_lshl_b32 s83, s83, 10
    s_add_u32 s83, s83, s78
    buffer_load_dwordx4 v[20:23], v11, s[56:59], s83 offen nt
    s_waitcnt vmcnt(7)
    s_cmp_eq_u32 s79, 2
    s_cselect_b32 s83, 2, 16
    s_lshl_b32 s83, s83, 10
    s_add_u32 s83, s83, s78
    buffer_load_dwordx4 v[24:27], v11, s[56:59], s83 offen nt
    s_waitcnt vmcnt(7)
    s_cmp_eq_u32 s79, 2
    s_cselect_b32 s83, 3, 24
    s_lshl_b32 s83, s83, 10
    s_add_u32 s83, s83, s78
    buffer_load_dwordx4 v[28:31], v11, s[56:59], s83 offen nt
    s_waitcnt vmcnt(7)
    s_cmp_eq_u32 s79, 2
    s_cselect_b32 s83, 4, 1
    s_lshl_b32 s83, s83, 10
    s_add_u32 s83, s83, s78
    buffer_load_dwordx4 v[32:35], v11, s[56:59], s83 offen nt
    s_waitcnt vmcnt(7)
    s_cmp_eq_u32 s79, 2
    s_cselect_b32 s83, 5, 9
    s_lshl_b32 s83, s83, 10
    s_add_u32 s83, s83, s78
    buffer_load_dwordx4 v[36:39], v11, s[56:59], s83 offen nt
    s_waitcnt vmcnt(7)
    s_cmp_eq_u32 s79, 2
    s_cselect_b32 s83, 6, 17
    s_lshl_b32 s83, s83, 10
    s_add_u32 s83, s83, s78
    buffer_load_dwordx4 v[40:43], v11, s[56:59], s83 offen nt
    s_waitcnt vmcnt(7)
    s_cmp_eq_u32 s79, 2
    s_cselect_b32 s83, 7, 25
    s_lshl_b32 s83, s83, 10
    s_add_u32 s83, s83, s78
    buffer_load_dwordx4 v[44:47], v11, s[56:59], s83 offen nt
    v_perm_b32 v112, v84, v80, s72
    v_perm_b32 v113, v92, v88, s72
    v_perm_b32 v114, v100, v96, s72
    v_perm_b32 v115, v108, v104, s72
    v_perm_b32 v116, v84, v80, s73
    v_perm_b32 v117, v92, v88, s73
    v_perm_b32 v118, v100, v96, s73
    v_perm_b32 v119, v108, v104, s73
    v_perm_b32 v120, v85, v81, s72
    v_perm_b32 v121, v93, v89, s72
    v_perm_b32 v122, v101, v97, s72
    v_perm_b32 v123, v109, v105, s72
    v_perm_b32 v124, v85, v81, s73
    v_perm_b32 v125, v93, v89, s73
    v_perm_b32 v126, v101, v97, s73
    v_perm_b32 v127, v109, v105, s73
    v_perm_b32 v128, v86, v82, s72
    v_perm_b32 v129, v94, v90, s72
    v_perm_b32 v130, v102, v98, s72
    v_perm_b32 v131, v110, v106, s72
    v_perm_b32 v132, v86, v82, s73
    v_perm_b32 v133, v94, v90, s73
    v_perm_b32 v134, v102, v98, s73
    v_perm_b32 v135, v110, v106, s73
    v_perm_b32 v136, v87, v83, s72
    v_perm_b32 v137, v95, v91, s72
    v_perm_b32 v138, v103, v99, s72
    v_perm_b32 v139, v111, v107, s72
    v_perm_b32 v140, v87, v83, s73
    v_perm_b32 v141, v95, v91, s73
    v_perm_b32 v142, v103, v99, s73
    v_perm_b32 v143, v111, v107, s73
    s_nop 1
    v_mfma_f32_16x16x32_bf16 v[144:147], v[112:115], v[212:215], v[144:147]
    v_mfma_f32_16x16x32_bf16 v[148:151], v[116:119], v[212:215], v[148:151]
    v_mfma_f32_16x16x32_bf16 v[152:155], v[120:123], v[212:215], v[152:155]
    v_mfma_f32_16x16x32_bf16 v[156:159], v[124:127], v[212:215], v[156:159]
    v_mfma_f32_16x16x32_bf16 v[160:163], v[128:131], v[212:215], v[160:163]
    v_mfma_f32_16x16x32_bf16 v[164:167], v[132:135], v[212:215], v[164:167]
    v_mfma_f32_16x16x32_bf16 v[168:171], v[136:139], v[212:215], v[168:171]
    v_mfma_f32_16x16x32_bf16 v[172:175], v[140:143], v[212:215], v[172:175]
    v_lshlrev_b32 v12, 9, v3
    v_lshl_add_u32 v12, v2, 7, v12
    s_lshl_b32 s81, s3, 11
    v_add_u32 v12, s81, v12
    v_cmp_gt_u32 vcc, 4, v3
    s_nop 4
    s_and_saveexec_b64 s[96:97], vcc
    ds_write_b128 v12, v[144:147] offset:25600
    ds_write_b128 v12, v[148:151] offset:25616
    ds_write_b128 v12, v[152:155] offset:25632
    ds_write_b128 v12, v[156:159] offset:25648
    ds_write_b128 v12, v[160:163] offset:25664
    ds_write_b128 v12, v[164:167] offset:25680
    ds_write_b128 v12, v[168:171] offset:25696
    ds_write_b128 v12, v[172:175] offset:25712
    s_mov_b64 exec, s[96:97]
    s_waitcnt lgkmcnt(0)
    s_barrier
    s_cmp_gt_u32 s3, 1
    s_cbranch_scc1 L_o_ml
    v_lshlrev_b32 v12, 4, v0
    ds_read_b128 v[112:115], v12 offset:25600
    ds_read_b128 v[116:119], v12 offset:27648
    ds_read_b128 v[120:123], v12 offset:29696
    ds_read_b128 v[124:127], v12 offset:31744
    s_waitcnt lgkmcnt(0)
    v_add_f32 v112, v112, v116
    v_add_f32 v120, v120, v124
    v_add_f32 v113, v113, v117
    v_add_f32 v121, v121, v125
    v_add_f32 v114, v114, v118
    v_add_f32 v122, v122, v126
    v_add_f32 v115, v115, v119
    v_add_f32 v123, v123, v127
    v_add_f32 v112, v112, v120
    v_add_f32 v113, v113, v121
    v_add_f32 v114, v114, v122
    v_add_f32 v115, v115, v123
    v_min_u32 v112, -2, v112
    v_min_u32 v113, -2, v113
    v_min_u32 v114, -2, v114
    v_min_u32 v115, -2, v115
    buffer_store_dwordx4 v[112:115], v12, s[60:63], s92 offen sc1
    s_branch L_o_done
L_o_ml:
    s_cmp_lg_u32 s3, 2
    s_cbranch_scc1 L_o_done
    v_and_b32 v12, 3, v1
    v_lshlrev_b32 v12, 6, v12
    ds_read_b128 v[112:115], v12 offset:24832
    ds_read_b128 v[116:119], v12 offset:24848
    ds_read_b128 v[120:123], v12 offset:24864
    ds_read_b128 v[124:127], v12 offset:24880
    ds_read_b128 v[128:131], v12 offset:24576
    ds_read_b128 v[132:135], v12 offset:24592
    ds_read_b128 v[136:139], v12 offset:24608
    ds_read_b128 v[140:143], v12 offset:24624
    s_waitcnt lgkmcnt(0)
    v_add_f32 v15, v112, v113
    v_add_f32 v15, v15, v114
    v_add_f32 v15, v15, v115
    v_add_f32 v15, v15, v116
    v_add_f32 v15, v15, v117
    v_add_f32 v15, v15, v118
    v_add_f32 v15, v15, v119
    v_add_f32 v15, v15, v120
    v_add_f32 v15, v15, v121
    v_add_f32 v15, v15, v122
    v_add_f32 v15, v15, v123
    v_add_f32 v15, v15, v124
    v_add_f32 v15, v15, v125
    v_add_f32 v15, v15, v126
    v_add_f32 v15, v15, v127
    v_max3_f32 v14, v128, v129, v130
    v_max3_f32 v14, v14, v131, v132
    v_max3_f32 v14, v14, v133, v134
    v_max3_f32 v14, v14, v135, v136
    v_max3_f32 v14, v14, v137, v138
    v_max3_f32 v14, v14, v139, v140
    v_max3_f32 v14, v14, v141, v142
    v_max_f32 v14, v14, v143
    v_min_u32 v14, -2, v14
    v_min_u32 v15, -2, v15
    v_lshlrev_b32 v12, 3, v1
    v_add_u32 v12, 2048, v12
    v_mov_b32 v112, 1073741824
    v_cmp_gt_u32 vcc, 4, v1
    s_nop 1
    v_cndmask_b32 v12, v112, v12, vcc
    buffer_store_dwordx2 v[14:15], v12, s[60:63], s92 offen sc1
L_o_done:
    s_cmp_eq_u32 s79, 0
    s_cbranch_scc1 L_final
    s_add_u32 s82, s88, 0
    buffer_load_dwordx4 v[216:219], v252, s[60:63], s82 offen sc1
    buffer_load_dwordx4 v[220:223], v252, s[60:63], s82 offen offset:16 sc1
    s_add_u32 s82, s88, 245760
    buffer_load_dwordx4 v[224:227], v252, s[60:63], s82 offen sc1
    buffer_load_dwordx4 v[228:231], v252, s[60:63], s82 offen offset:16 sc1
    s_add_u32 s82, s88, 491520
    buffer_load_dwordx4 v[232:235], v252, s[60:63], s82 offen sc1
    buffer_load_dwordx4 v[236:239], v252, s[60:63], s82 offen offset:16 sc1
    s_add_u32 s82, s88, 737280
    buffer_load_dwordx4 v[240:243], v252, s[60:63], s82 offen sc1
    buffer_load_dwordx4 v[244:247], v252, s[60:63], s82 offen offset:16 sc1
    s_waitcnt vmcnt(0)
    v_perm_b32 v112, v20, v16, s72
    v_perm_b32 v113, v28, v24, s72
    v_perm_b32 v114, v36, v32, s72
    v_perm_b32 v115, v44, v40, s72
    v_perm_b32 v116, v20, v16, s73
    v_perm_b32 v117, v28, v24, s73
    v_perm_b32 v118, v36, v32, s73
    v_perm_b32 v119, v44, v40, s73
    v_perm_b32 v120, v21, v17, s72
    v_perm_b32 v121, v29, v25, s72
    v_perm_b32 v122, v37, v33, s72
    v_perm_b32 v123, v45, v41, s72
    v_perm_b32 v124, v21, v17, s73
    v_perm_b32 v125, v29, v25, s73
    v_perm_b32 v126, v37, v33, s73
    v_perm_b32 v127, v45, v41, s73
    v_perm_b32 v128, v22, v18, s72
    v_perm_b32 v129, v30, v26, s72
    v_perm_b32 v130, v38, v34, s72
    v_perm_b32 v131, v46, v42, s72
    v_perm_b32 v132, v22, v18, s73
    v_perm_b32 v133, v30, v26, s73
    v_perm_b32 v134, v38, v34, s73
    v_perm_b32 v135, v46, v42, s73
    v_perm_b32 v136, v23, v19, s72
    v_perm_b32 v137, v31, v27, s72
    v_perm_b32 v138, v39, v35, s72
    v_perm_b32 v139, v47, v43, s72
    v_perm_b32 v140, v23, v19, s73
    v_perm_b32 v141, v31, v27, s73
    v_perm_b32 v142, v39, v35, s73
    v_perm_b32 v143, v47, v43, s73
    s_cmp_eq_u32 s79, 2
    s_cbranch_scc0 L_p3_wo
    s_mov_b32 s90, 0
L_h_chk:
    v_max3_u32 v14, v216, v217, v218
    v_max3_u32 v14, v14, v219, v220
    v_max3_u32 v14, v14, v221, v222
    v_max3_u32 v14, v14, v223, v224
    v_max3_u32 v14, v14, v225, v226
    v_max3_u32 v14, v14, v227, v228
    v_max3_u32 v14, v14, v229, v230
    v_max3_u32 v14, v14, v231, v232
    v_max3_u32 v14, v14, v233, v234
    v_max3_u32 v14, v14, v235, v236
    v_max3_u32 v14, v14, v237, v238
    v_max3_u32 v14, v14, v239, v240
    v_max3_u32 v14, v14, v241, v242
    v_max3_u32 v14, v14, v243, v244
    v_max3_u32 v14, v14, v245, v246
    v_max_u32 v14, v14, v247
    v_cmp_eq_u32 vcc, -1, v14
    s_cmp_eq_u64 vcc, 0
    s_cbranch_scc1 L_h_ok
    s_add_u32 s90, s90, 1
    s_cmp_gt_u32 s90, 20000
    s_cbranch_scc1 L_h_ok
    s_add_u32 s82, s88, 0
    buffer_load_dwordx4 v[216:219], v252, s[60:63], s82 offen sc1
    buffer_load_dwordx4 v[220:223], v252, s[60:63], s82 offen offset:16 sc1
    s_add_u32 s82, s88, 245760
    buffer_load_dwordx4 v[224:227], v252, s[60:63], s82 offen sc1
    buffer_load_dwordx4 v[228:231], v252, s[60:63], s82 offen offset:16 sc1
    s_add_u32 s82, s88, 491520
    buffer_load_dwordx4 v[232:235], v252, s[60:63], s82 offen sc1
    buffer_load_dwordx4 v[236:239], v252, s[60:63], s82 offen offset:16 sc1
    s_add_u32 s82, s88, 737280
    buffer_load_dwordx4 v[240:243], v252, s[60:63], s82 offen sc1
    buffer_load_dwordx4 v[244:247], v252, s[60:63], s82 offen offset:16 sc1
    s_waitcnt vmcnt(0)
    s_branch L_h_chk
L_h_ok:
    v_add_f32 v216, v216, v224
    v_add_f32 v232, v232, v240
    v_add_f32 v217, v217, v225
    v_add_f32 v233, v233, v241
    v_add_f32 v218, v218, v226
    v_add_f32 v234, v234, v242
    v_add_f32 v219, v219, v227
    v_add_f32 v235, v235, v243
    v_add_f32 v220, v220, v228
    v_add_f32 v236, v236, v244
    v_add_f32 v221, v221, v229
    v_add_f32 v237, v237, v245
    v_add_f32 v222, v222, v230
    v_add_f32 v238, v238, v246
    v_add_f32 v223, v223, v231
    v_add_f32 v239, v239, v247
    v_add_f32 v216, v216, v232
    v_add_f32 v217, v217, v233
    v_add_f32 v218, v218, v234
    v_add_f32 v219, v219, v235
    v_add_f32 v220, v220, v236
    v_add_f32 v221, v221, v237
    v_add_f32 v222, v222, v238
    v_add_f32 v223, v223, v239
    v_cvt_pk_bf16_f32 v224, v216, v217
    v_cvt_pk_bf16_f32 v225, v218, v219
    v_cvt_pk_bf16_f32 v226, v220, v221
    v_cvt_pk_bf16_f32 v227, v222, v223
    v_lshlrev_b32 v216, 16, v224
    v_and_b32 v217, 0xffff0000, v224
    v_lshlrev_b32 v218, 16, v225
    v_and_b32 v219, 0xffff0000, v225
    v_lshlrev_b32 v220, 16, v226
    v_and_b32 v221, 0xffff0000, v226
    v_lshlrev_b32 v222, 16, v227
    v_and_b32 v223, 0xffff0000, v227
    s_nop 1
    v_mul_f32_dpp v232, v216, v216 row_ror:8 row_mask:0xf bank_mask:0xf
    v_mul_f32_dpp v233, v217, v217 row_ror:8 row_mask:0xf bank_mask:0xf
    v_mul_f32_dpp v234, v218, v218 row_ror:8 row_mask:0xf bank_mask:0xf
    v_mul_f32_dpp v235, v219, v219 row_ror:8 row_mask:0xf bank_mask:0xf
    v_mul_f32_dpp v236, v220, v220 row_ror:8 row_mask:0xf bank_mask:0xf
    v_mul_f32_dpp v237, v221, v221 row_ror:8 row_mask:0xf bank_mask:0xf
    v_mul_f32_dpp v238, v222, v222 row_ror:8 row_mask:0xf bank_mask:0xf
    v_mul_f32_dpp v239, v223, v223 row_ror:8 row_mask:0xf bank_mask:0xf
    v_cvt_pk_bf16_f32 v248, v232, v233
    v_cvt_pk_bf16_f32 v249, v234, v235
    v_cvt_pk_bf16_f32 v250, v236, v237
    v_cvt_pk_bf16_f32 v251, v238, v239
    s_branch L_p3_mm
L_p3_wo:
    v_and_b32 v12, 7, v3
    v_lshlrev_b32 v12, 17, v12
    v_lshrrev_b32 v14, 3, v3
    v_lshl_add_u32 v12, v14, 13, v12
    v_lshl_add_u32 v15, v2, 5, v12
    s_add_u32 s81, s89, 4096
    s_add_u32 s82, s98, 4096
    s_mov_b32 s90, 0
    buffer_load_dwordx4 v[48:51], v15, s[60:63], s89 offen sc1
    buffer_load_dwordx4 v[52:55], v15, s[60:63], s89 offen offset:16 sc1
    buffer_load_dwordx4 v[56:59], v15, s[60:63], s81 offen sc1
    buffer_load_dwordx4 v[60:63], v15, s[60:63], s81 offen offset:16 sc1
    buffer_load_dwordx2 v[64:65], v12, s[60:63], s98 offen sc1
    buffer_load_dwordx2 v[66:67], v12, s[60:63], s82 offen sc1
L_og:
    s_waitcnt vmcnt(0)
    v_max3_u32 v14, v48, v49, v50
    v_max3_u32 v14, v14, v51, v52
    v_max3_u32 v14, v14, v53, v54
    v_max3_u32 v14, v14, v55, v56
    v_max3_u32 v14, v14, v57, v58
    v_max3_u32 v14, v14, v59, v60
    v_max3_u32 v14, v14, v61, v62
    v_max3_u32 v14, v14, v63, v64
    v_max3_u32 v14, v14, v65, v66
    v_max_u32 v14, v14, v67
    v_cmp_eq_u32 vcc, -1, v14
    s_cmp_eq_u64 vcc, 0
    s_cbranch_scc1 L_og_ok
    s_add_u32 s90, s90, 1
    s_cmp_gt_u32 s90, 20000
    s_cbranch_scc1 L_og_ok
    s_mov_b64 exec, vcc
    buffer_load_dwordx4 v[48:51], v15, s[60:63], s89 offen sc1
    buffer_load_dwordx4 v[52:55], v15, s[60:63], s89 offen offset:16 sc1
    buffer_load_dwordx4 v[56:59], v15, s[60:63], s81 offen sc1
    buffer_load_dwordx4 v[60:63], v15, s[60:63], s81 offen offset:16 sc1
    buffer_load_dwordx2 v[64:65], v12, s[60:63], s98 offen sc1
    buffer_load_dwordx2 v[66:67], v12, s[60:63], s82 offen sc1
    s_mov_b64 exec, -1
    s_branch L_og
L_og_ok:
    v_max_f32 v192, v64, v66
    s_nop 1
    v_max_f32_dpp v192, v192, v192 row_ror:8 row_mask:0xf bank_mask:0xf
    v_sub_f32 v193, v64, v192
    v_sub_f32 v194, v66, v192
    v_mul_f32 v193, s91, v193
    v_mul_f32 v194, s91, v194
    v_exp_f32 v193, v193
    v_exp_f32 v194, v194
    s_nop 0
    v_mul_f32 v195, v193, v65
    v_fmac_f32 v195, v194, v67
    v_mul_f32 v48, v193, v48
    v_mul_f32 v49, v193, v49
    v_mul_f32 v50, v193, v50
    v_mul_f32 v51, v193, v51
    v_mul_f32 v52, v193, v52
    v_mul_f32 v53, v193, v53
    v_mul_f32 v54, v193, v54
    v_mul_f32 v55, v193, v55
    v_fmac_f32 v48, v194, v56
    v_fmac_f32 v49, v194, v57
    v_fmac_f32 v50, v194, v58
    v_fmac_f32 v51, v194, v59
    v_fmac_f32 v52, v194, v60
    v_fmac_f32 v53, v194, v61
    v_fmac_f32 v54, v194, v62
    v_fmac_f32 v55, v194, v63
    v_add_f32_dpp v195, v195, v195 row_ror:8 row_mask:0xf bank_mask:0xf
    v_add_f32_dpp v48, v48, v48 row_ror:8 row_mask:0xf bank_mask:0xf
    v_add_f32_dpp v49, v49, v49 row_ror:8 row_mask:0xf bank_mask:0xf
    v_add_f32_dpp v50, v50, v50 row_ror:8 row_mask:0xf bank_mask:0xf
    v_add_f32_dpp v51, v51, v51 row_ror:8 row_mask:0xf bank_mask:0xf
    v_add_f32_dpp v52, v52, v52 row_ror:8 row_mask:0xf bank_mask:0xf
    v_add_f32_dpp v53, v53, v53 row_ror:8 row_mask:0xf bank_mask:0xf
    v_add_f32_dpp v54, v54, v54 row_ror:8 row_mask:0xf bank_mask:0xf
    v_add_f32_dpp v55, v55, v55 row_ror:8 row_mask:0xf bank_mask:0xf
    v_rcp_f32 v193, v195
    s_nop 0
    v_mul_f32 v56, v48, v193
    v_fma_f32 v57, -v56, v195, v48
    v_fma_f32 v48, v57, v193, v56
    v_mul_f32 v56, v49, v193
    v_fma_f32 v57, -v56, v195, v49
    v_fma_f32 v49, v57, v193, v56
    v_mul_f32 v56, v50, v193
    v_fma_f32 v57, -v56, v195, v50
    v_fma_f32 v50, v57, v193, v56
    v_mul_f32 v56, v51, v193
    v_fma_f32 v57, -v56, v195, v51
    v_fma_f32 v51, v57, v193, v56
    v_mul_f32 v56, v52, v193
    v_fma_f32 v57, -v56, v195, v52
    v_fma_f32 v52, v57, v193, v56
    v_mul_f32 v56, v53, v193
    v_fma_f32 v57, -v56, v195, v53
    v_fma_f32 v53, v57, v193, v56
    v_mul_f32 v56, v54, v193
    v_fma_f32 v57, -v56, v195, v54
    v_fma_f32 v54, v57, v193, v56
    v_mul_f32 v56, v55, v193
    v_fma_f32 v57, -v56, v195, v55
    v_fma_f32 v55, v57, v193, v56
    v_cvt_pk_bf16_f32 v248, v48, v49
    v_cvt_pk_bf16_f32 v249, v50, v51
    v_cvt_pk_bf16_f32 v250, v52, v53
    v_cvt_pk_bf16_f32 v251, v54, v55
L_p3_mm:
    s_nop 1
    v_mfma_f32_16x16x32_bf16 v[144:147], v[112:115], v[248:251], 0
    v_mfma_f32_16x16x32_bf16 v[148:151], v[116:119], v[248:251], 0
    v_mfma_f32_16x16x32_bf16 v[152:155], v[120:123], v[248:251], 0
    v_mfma_f32_16x16x32_bf16 v[156:159], v[124:127], v[248:251], 0
    v_mfma_f32_16x16x32_bf16 v[160:163], v[128:131], v[248:251], 0
    v_mfma_f32_16x16x32_bf16 v[164:167], v[132:135], v[248:251], 0
    v_mfma_f32_16x16x32_bf16 v[168:171], v[136:139], v[248:251], 0
    v_mfma_f32_16x16x32_bf16 v[172:175], v[140:143], v[248:251], 0
    v_and_b32 v12, 7, v3
    v_lshlrev_b32 v12, 9, v12
    v_lshl_add_u32 v12, v2, 7, v12
    s_lshl_b32 s81, s3, 12
    v_add_u32 v12, s81, v12
    v_cmp_gt_u32 vcc, 8, v3
    s_nop 4
    s_and_saveexec_b64 s[96:97], vcc
    ds_write_b128 v12, v[144:147] offset:33792
    ds_write_b128 v12, v[148:151] offset:33808
    ds_write_b128 v12, v[152:155] offset:33824
    ds_write_b128 v12, v[156:159] offset:33840
    ds_write_b128 v12, v[160:163] offset:33856
    ds_write_b128 v12, v[164:167] offset:33872
    ds_write_b128 v12, v[168:171] offset:33888
    ds_write_b128 v12, v[172:175] offset:33904
    s_mov_b64 exec, s[96:97]
    s_waitcnt lgkmcnt(0)
    s_barrier
    v_lshlrev_b32 v12, 4, v0
    ds_read_b128 v[112:115], v12 offset:33792
    ds_read_b128 v[116:119], v12 offset:37888
    ds_read_b128 v[120:123], v12 offset:41984
    ds_read_b128 v[124:127], v12 offset:46080
    s_waitcnt lgkmcnt(0)
    v_add_f32 v112, v112, v116
    v_add_f32 v120, v120, v124
    v_add_f32 v113, v113, v117
    v_add_f32 v121, v121, v125
    v_add_f32 v114, v114, v118
    v_add_f32 v122, v122, v126
    v_add_f32 v115, v115, v119
    v_add_f32 v123, v123, v127
    v_add_f32 v112, v112, v120
    v_add_f32 v113, v113, v121
    v_add_f32 v114, v114, v122
    v_add_f32 v115, v115, v123
    v_min_u32 v112, -2, v112
    v_min_u32 v113, -2, v113
    v_min_u32 v114, -2, v114
    v_min_u32 v115, -2, v115
    buffer_store_dwordx4 v[112:115], v5, s[60:63], s80 offen sc1
L_final:
    s_cmp_lg_u32 s3, 0
    s_cbranch_scc1 L_exit
    s_lshr_b32 s81, s2, 5
    s_lshl_b32 s81, s81, 11
    s_and_b32 s82, s2, 31
    s_lshl_b32 s83, s82, 6
    s_add_u32 s81, s81, s83
    s_add_u32 s81, s81, 2097152
    s_add_u32 s83, s81, 262144
    s_add_u32 s84, s81, 524288
    v_lshrrev_b32 v12, 2, v1
    v_lshlrev_b32 v14, 14, v12
    v_and_b32 v15, 3, v1
    v_lshl_add_u32 v14, v15, 4, v14
    v_mov_b32 v16, 1073741824
    v_cmp_gt_u32 vcc, 14, v12
    s_nop 1
    v_cndmask_b32 v16, v16, v14, vcc
    s_lshr_b32 s85, s2, 5
    s_lshl_b32 s85, s85, 10
    s_lshr_b32 s86, s82, 1
    s_lshl_b32 s86, s86, 6
    s_add_u32 s85, s85, s86
    s_and_b32 s86, s82, 1
    s_lshl_b32 s86, s86, 3
    s_add_u32 s85, s85, s86
    v_lshlrev_b32 v17, 1, v15
    v_add_u32 v17, s85, v17
    v_mov_b32 v18, 1073741824
    v_cmp_gt_u32 vcc, 4, v1
    s_nop 1
    v_cndmask_b32 v17, v18, v17, vcc
    buffer_load_ushort v40, v17, s[40:43], 0 offen offset:0
    buffer_load_ushort v41, v17, s[40:43], 0 offen offset:16
    buffer_load_ushort v42, v17, s[40:43], 0 offen offset:32
    buffer_load_ushort v43, v17, s[40:43], 0 offen offset:48
    v_mov_b32 v19, v14
    s_mov_b32 s90, 0
    buffer_load_dwordx4 v[20:23], v19, s[60:63], s81 offen sc1
    buffer_load_dwordx4 v[24:27], v19, s[60:63], s83 offen sc1
    buffer_load_dwordx4 v[28:31], v16, s[60:63], s84 offen sc1
L_fin:
    s_waitcnt vmcnt(0)
    v_max3_u32 v14, v20, v21, v22
    v_max3_u32 v14, v14, v23, v24
    v_max3_u32 v14, v14, v25, v26
    v_max3_u32 v14, v14, v27, v28
    v_max3_u32 v14, v14, v29, v30
    v_max_u32 v14, v14, v31
    v_cmp_eq_u32 vcc, -1, v14
    s_cmp_eq_u64 vcc, 0
    s_cbranch_scc1 L_fin_ok
    s_add_u32 s90, s90, 1
    s_cmp_gt_u32 s90, 20000
    s_cbranch_scc1 L_fin_ok
    s_mov_b64 exec, vcc
    buffer_load_dwordx4 v[20:23], v19, s[60:63], s81 offen sc1
    buffer_load_dwordx4 v[24:27], v19, s[60:63], s83 offen sc1
    buffer_load_dwordx4 v[28:31], v16, s[60:63], s84 offen sc1
    s_mov_b64 exec, -1
    s_branch L_fin
L_fin_ok:
    v_add_f32 v20, v20, v24
    v_add_f32 v21, v21, v25
    v_add_f32 v22, v22, v26
    v_add_f32 v23, v23, v27
    v_mov_b32 v24, v28
    v_mov_b32 v25, v29
    v_mov_b32 v26, v30
    v_mov_b32 v27, v31
    s_nop 1
    v_add_f32_dpp v20, v20, v20 row_ror:4 row_mask:0xf bank_mask:0xf
    v_add_f32_dpp v21, v21, v21 row_ror:4 row_mask:0xf bank_mask:0xf
    v_add_f32_dpp v22, v22, v22 row_ror:4 row_mask:0xf bank_mask:0xf
    v_add_f32_dpp v23, v23, v23 row_ror:4 row_mask:0xf bank_mask:0xf
    v_add_f32_dpp v24, v24, v24 row_ror:4 row_mask:0xf bank_mask:0xf
    v_add_f32_dpp v25, v25, v25 row_ror:4 row_mask:0xf bank_mask:0xf
    v_add_f32_dpp v26, v26, v26 row_ror:4 row_mask:0xf bank_mask:0xf
    v_add_f32_dpp v27, v27, v27 row_ror:4 row_mask:0xf bank_mask:0xf
    v_add_f32_dpp v20, v20, v20 row_ror:8 row_mask:0xf bank_mask:0xf
    v_add_f32_dpp v21, v21, v21 row_ror:8 row_mask:0xf bank_mask:0xf
    v_add_f32_dpp v22, v22, v22 row_ror:8 row_mask:0xf bank_mask:0xf
    v_add_f32_dpp v23, v23, v23 row_ror:8 row_mask:0xf bank_mask:0xf
    v_add_f32_dpp v24, v24, v24 row_ror:8 row_mask:0xf bank_mask:0xf
    v_add_f32_dpp v25, v25, v25 row_ror:8 row_mask:0xf bank_mask:0xf
    v_add_f32_dpp v26, v26, v26 row_ror:8 row_mask:0xf bank_mask:0xf
    v_add_f32_dpp v27, v27, v27 row_ror:8 row_mask:0xf bank_mask:0xf
    ds_swizzle_b32 v28, v20 offset:0x401F
    ds_swizzle_b32 v29, v21 offset:0x401F
    ds_swizzle_b32 v30, v22 offset:0x401F
    ds_swizzle_b32 v31, v23 offset:0x401F
    ds_swizzle_b32 v32, v24 offset:0x401F
    ds_swizzle_b32 v33, v25 offset:0x401F
    ds_swizzle_b32 v34, v26 offset:0x401F
    ds_swizzle_b32 v35, v27 offset:0x401F
    s_waitcnt lgkmcnt(0)
    v_add_f32 v20, v20, v28
    v_add_f32 v21, v21, v29
    v_add_f32 v22, v22, v30
    v_add_f32 v23, v23, v31
    v_add_f32 v24, v24, v32
    v_add_f32 v25, v25, v33
    v_add_f32 v26, v26, v34
    v_add_f32 v27, v27, v35
    v_mov_b32 v28, v20
    v_mov_b32 v29, v21
    v_mov_b32 v30, v22
    v_mov_b32 v31, v23
    v_mov_b32 v32, v24
    v_mov_b32 v33, v25
    v_mov_b32 v34, v26
    v_mov_b32 v35, v27
    s_nop 1
    v_permlane32_swap_b32 v20, v28
    v_permlane32_swap_b32 v21, v29
    v_permlane32_swap_b32 v22, v30
    v_permlane32_swap_b32 v23, v31
    v_permlane32_swap_b32 v24, v32
    v_permlane32_swap_b32 v25, v33
    v_permlane32_swap_b32 v26, v34
    v_permlane32_swap_b32 v27, v35
    v_add_f32 v20, v20, v28
    v_add_f32 v21, v21, v29
    v_add_f32 v22, v22, v30
    v_add_f32 v23, v23, v31
    v_add_f32 v24, v24, v32
    v_add_f32 v25, v25, v33
    v_add_f32 v26, v26, v34
    v_add_f32 v27, v27, v35
    v_cvt_pk_bf16_f32 v28, v20, v21
    v_cvt_pk_bf16_f32 v29, v22, v23
    v_cvt_pk_bf16_f32 v30, v24, v25
    v_cvt_pk_bf16_f32 v31, v26, v27
    v_lshlrev_b32 v20, 16, v28
    v_and_b32 v21, 0xffff0000, v28
    v_lshlrev_b32 v24, 16, v30
    v_and_b32 v25, 0xffff0000, v30
    v_lshlrev_b32 v22, 16, v29
    v_and_b32 v23, 0xffff0000, v29
    v_lshlrev_b32 v26, 16, v31
    v_and_b32 v27, 0xffff0000, v31
    v_mul_f32 v28, s91, v24
    v_mul_f32 v29, s91, v25
    v_mul_f32 v30, s91, v26
    v_mul_f32 v31, s91, v27
    v_exp_f32 v28, -v28
    v_exp_f32 v29, -v29
    v_exp_f32 v30, -v30
    v_exp_f32 v31, -v31
    s_nop 0
    v_add_f32 v28, 1.0, v28
    v_add_f32 v29, 1.0, v29
    v_add_f32 v30, 1.0, v30
    v_add_f32 v31, 1.0, v31
    v_rcp_f32 v32, v28
    v_rcp_f32 v33, v29
    v_rcp_f32 v34, v30
    v_rcp_f32 v35, v31
    s_nop 0
    v_mul_f32 v36, v24, v32
    v_fma_f32 v37, -v36, v28, v24
    v_fma_f32 v24, v37, v32, v36
    v_mul_f32 v36, v25, v33
    v_fma_f32 v37, -v36, v29, v25
    v_fma_f32 v25, v37, v33, v36
    v_mul_f32 v36, v26, v34
    v_fma_f32 v37, -v36, v30, v26
    v_fma_f32 v26, v37, v34, v36
    v_mul_f32 v36, v27, v35
    v_fma_f32 v37, -v36, v31, v27
    v_fma_f32 v27, v37, v35, v36
    v_cvt_pk_bf16_f32 v30, v24, v25
    v_cvt_pk_bf16_f32 v31, v26, v27
    v_lshlrev_b32 v24, 16, v30
    v_and_b32 v25, 0xffff0000, v30
    v_lshlrev_b32 v26, 16, v31
    v_and_b32 v27, 0xffff0000, v31
    v_mul_f32 v20, v20, v24
    v_mul_f32 v21, v21, v25
    v_mul_f32 v22, v22, v26
    v_mul_f32 v23, v23, v27
    v_cvt_pk_bf16_f32 v28, v20, v21
    v_cvt_pk_bf16_f32 v29, v22, v23
    v_lshlrev_b32 v20, 16, v28
    v_and_b32 v21, 0xffff0000, v28
    v_lshlrev_b32 v22, 16, v29
    v_and_b32 v23, 0xffff0000, v29
    v_lshlrev_b32 v40, 16, v40
    v_add_f32 v20, v20, v40
    v_lshlrev_b32 v41, 16, v41
    v_add_f32 v21, v21, v41
    v_lshlrev_b32 v42, 16, v42
    v_add_f32 v22, v22, v42
    v_lshlrev_b32 v43, 16, v43
    v_add_f32 v23, v23, v43
    v_cvt_pk_bf16_f32 v24, v20, v20
    v_cvt_pk_bf16_f32 v25, v21, v21
    v_cvt_pk_bf16_f32 v26, v22, v22
    v_cvt_pk_bf16_f32 v27, v23, v23
    buffer_store_short v24, v17, s[68:71], 0 offen offset:0
    buffer_store_short v25, v17, s[68:71], 0 offen offset:16
    buffer_store_short v26, v17, s[68:71], 0 offen offset:32
    buffer_store_short v27, v17, s[68:71], 0 offen offset:48
L_exit:
L_end:
    s_endpgm
.section .rodata,"a"
.p2align 6
.amdhsa_kernel recurrent_scan__sliding_block_cached__glu_gated_bilinear__decode_kernel
  .amdhsa_next_free_vgpr 320
  .amdhsa_next_free_sgpr 102
  .amdhsa_accum_offset 256
  .amdhsa_group_segment_fixed_size 0
  .amdhsa_kernarg_size 96
  .amdhsa_user_sgpr_count 2
  .amdhsa_user_sgpr_kernarg_segment_ptr 1
  .amdhsa_system_sgpr_workgroup_id_x 1
.end_amdhsa_kernel
```
